```python
import torch

def _softmax(x, axis=-1):
    return torch.softmax(x, dim=axis)
def _gelu(x):
    return torch.nn.functional.gelu(x, approximate="tanh")
def _silu(x):
    return torch.nn.functional.silu(x)
def _sigmoid(x):
    return torch.sigmoid(x)
def _layernorm(x, axis=-1, eps=1e-5):
    m = x.mean(dim=axis, keepdim=True)
    v = x.var(dim=axis, keepdim=True, unbiased=False)
    return (x - m) / torch.sqrt(v + eps)
def _scatter_add(tgt, idx, src, axis=0):
    return tgt.clone().index_add_(axis, idx, src)
def _segment_sum(src, seg, n):
    out = torch.zeros((n,) + src.shape[1:], dtype=src.dtype)
    return out.index_add_(0, seg, src)
def _pad(x, pw):
    flat = tuple(v for pair in reversed(pw) for v in pair)
    return torch.nn.functional.pad(x, flat)

kernel_name = 'standalone__paged_block_table_kv_radixattention__sampling'

def setup_inputs():

    _w = (lambda a: (lambda t: t.to(torch.bfloat16) if t.is_floating_point() else t)(torch.as_tensor(a)))
    B, H, Hkv, Dh = 32, 32, 16, 128
    Lk = 2048
    bs = 16
    nb = max(2, Lk // bs)
    P = max(1, nb // 2)
    n_phys = P + B * (nb - P)
    shared = torch.arange(P, dtype=torch.int64)
    priv = P + torch.arange(B * (nb - P), dtype=torch.int64).reshape(B, nb - P)
    bt = torch.cat([torch.tile(shared[None, :], (B, 1)), priv], dim=1)
    ctx = nb * bs - (torch.arange(1, B + 1, dtype=torch.int64) * 2654435761) % max(1, (nb * bs - P * bs) // 2)
    return {
        "q": _w((lambda *s: torch.randn(*s, dtype=torch.bfloat16) * 0.8)(B, H, Dh)),
        "k_cache": _w((lambda *s: torch.randn(*s, dtype=torch.bfloat16) * 0.8)(n_phys, bs, Hkv, Dh)),
        "v_cache": _w((lambda *s: torch.randn(*s, dtype=torch.bfloat16) * 0.05)(n_phys, bs, Hkv, Dh)),
        "block_table": _w(bt.to(torch.int64)),
        "ctx_lens": _w(torch.as_tensor(ctx).to(torch.int64)),
    }

def reference(q, k_cache, v_cache, block_table, ctx_lens):
    B, H, Dh = q.shape
    n_phys, bs, Hkv, _ = k_cache.shape
    nb = block_table.shape[1]
    Lk = nb * bs
    rep = H // Hkv
    k = k_cache[block_table].reshape(B, Lk, Hkv, Dh)
    v = v_cache[block_table].reshape(B, Lk, Hkv, Dh)
    k = (lambda x, n, axis: torch.repeat_interleave(x, n, dim=axis))(k, rep, axis=2)
    v = (lambda x, n, axis: torch.repeat_interleave(x, n, dim=axis))(v, rep, axis=2)
    scores = torch.einsum("bhd,bkhd->bhk", q, k) * (Dh ** -0.5)
    pos = torch.arange(Lk)
    valid = pos[None, :] < ctx_lens[:, None]
    scores = torch.where(valid[:, None, :], scores, -1e9)
    p = _softmax(scores, axis=-1)
    return torch.einsum("bhk,bkhd->bhd", p, v)
```

```asm
; @launch grid=(256,1,1) block=(320,1,1) lds=66112
.amdgcn_target "amdgcn-amd-amdhsa--gfx950"
.text
.globl standalone__paged_block_table_kv_radixattention__sampling_kernel
.p2align 8
.type standalone__paged_block_table_kv_radixattention__sampling_kernel,@function
standalone__paged_block_table_kv_radixattention__sampling_kernel:
    s_cmp_ge_u32 s2, 256
    s_cbranch_scc1 L_end
    s_load_dwordx8 s[4:11], s[0:1], 0
    s_load_dwordx4 s[12:15], s[0:1], 32
    s_load_dwordx4 s[76:79], s[0:1], 48
    v_lshrrev_b32 v1, 6, v0
    v_and_b32 v0, 63, v0
    s_add_u32 s3, s2, 2
    s_and_b32 s41, s3, 15
    s_lshr_b32 s42, s2, 4
    v_readfirstlane_b32 s40, v1
    s_cmp_lt_u32 s40, 4
    s_cbranch_scc1 L_npf
    s_getpc_b64 s[90:91]
L_pc:
    v_lshlrev_b32 v160, 7, v0
    v_min_u32 v161, L_end-L_pc, v160
    v_mov_b32 v163, s91
    v_add_co_u32 v162, vcc, s90, v161
    s_nop 1
    v_addc_co_u32 v163, vcc, 0, v163, vcc
    global_load_dword v164, v[162:163], off
    v_add_u32 v160, 8192, v160
    v_min_u32 v161, L_end-L_pc, v160
    v_mov_b32 v163, s91
    v_add_co_u32 v162, vcc, s90, v161
    s_nop 1
    v_addc_co_u32 v163, vcc, 0, v163, vcc
    global_load_dword v165, v[162:163], off
L_npf:
    s_add_u32 s96, s42, 2
    s_sub_u32 s97, 33, s42
    s_sub_u32 s3, 3, s42
    s_cmp_lt_u32 s42, 2
    s_cselect_b32 s59, 1, 0
    s_cselect_b32 s96, s42, s96
    s_cselect_b32 s97, s3, s97
    v_and_b32 v64, 31, v0
    v_lshrrev_b32 v65, 5, v0
    v_and_b32 v66, 15, v0
    v_lshl_add_u32 v65, v65, 4, v66
    v_lshlrev_b32 v66, 2, v64
    v_lshlrev_b32 v67, 2, v65
    v_lshlrev_b32 v68, 4, v64
    s_lshl_b32 s68, s40, 12
    v_lshl_add_u32 v69, v0, 4, s68
    s_waitcnt lgkmcnt(0)
    s_mov_b32 s32, s12
    s_mov_b32 s33, s13
    s_mov_b32 s34, 128
    s_mov_b32 s35, 0x20000
    s_mov_b32 s28, s10
    s_mov_b32 s29, s11
    s_mov_b32 s30, 16384
    s_mov_b32 s31, 0x20000
    buffer_load_dword v62, v66, s[32:35], 0 offen
    buffer_load_dword v70, v67, s[32:35], 0 offen
    buffer_load_dwordx4 v[72:75], v68, s[28:31], 0 offen
    buffer_load_dwordx4 v[76:79], v69, s[28:31], 0 offen offset:0
    buffer_load_dwordx4 v[80:83], v69, s[28:31], 0 offen offset:1024
    buffer_load_dwordx4 v[84:87], v69, s[28:31], 0 offen offset:2048
    buffer_load_dwordx4 v[88:91], v69, s[28:31], 0 offen offset:3072
    s_mov_b32 s16, s6
    s_mov_b32 s17, s7
    s_mov_b32 s18, 138412032
    s_mov_b32 s19, 0x20000
    s_mov_b32 s20, s8
    s_mov_b32 s21, s9
    s_mov_b32 s22, 138412032
    s_mov_b32 s23, 0x20000
    s_mov_b32 s24, s4
    s_mov_b32 s25, s5
    s_mov_b32 s26, 262144
    s_mov_b32 s27, 0x20000
    s_mov_b32 s36, s14
    s_mov_b32 s37, s15
    s_mov_b32 s38, 262144
    s_mov_b32 s39, 0x20000
    s_mov_b32 s84, s76
    s_mov_b32 s85, s77
    s_mov_b32 s86, 256
    s_mov_b32 s87, 0x20000
    s_mov_b32 s88, s78
    s_mov_b32 s89, s79
    s_mov_b32 s90, 540672
    s_mov_b32 s91, 0x20000
    v_lshrrev_b32 v8, 4, v0
    v_and_b32 v92, 15, v0
    v_lshlrev_b32 v92, 4, v92
    v_lshl_add_u32 v2, v8, 12, v92
    v_and_b32 v92, 3, v0
    v_lshlrev_b32 v92, 4, v92
    v_lshl_add_u32 v92, v8, 6, v92
    v_bfe_u32 v93, v0, 2, 2
    v_lshl_add_u32 v1, v93, 12, v92
    v_bfe_u32 v93, v0, 2, 1
    v_lshl_add_u32 v39, v93, 8, v92
    v_and_b32 v93, 1, v0
    v_lshlrev_b32 v93, 4, v93
    v_mov_b32 v3, 0xffff
    v_lshlrev_b32 v3, v93, v3
    v_bfe_i32 v93, v0, 1, 1
    v_and_b32 v4, v3, v93
    v_xor_b32 v3, v3, v4
    v_and_b32 v5, 8, v0
    v_lshrrev_b32 v5, 1, v5
    v_add_u32 v9, 8, v5
    v_add_u32 v10, 16, v5
    v_add_u32 v11, 24, v5
    v_mov_b32 v6, 0x3e0293ee
    v_mov_b32 v7, 0xff800000
    v_mov_b32 v22, 0
    v_mov_b32 v23, 0
    v_mov_b32 v24, 0
    v_mov_b32 v25, 0
    v_mov_b32 v26, 0
    v_mov_b32 v27, 0
    v_mov_b32 v28, 0
    v_mov_b32 v29, 0
    v_mov_b32 v30, 0xf149f2ca
    v_mov_b32 v31, 0
    v_mov_b32 v52, 0
    v_mov_b32 v53, 0
    v_mov_b32 v56, 0
    v_mov_b32 v57, 0
    v_mov_b32 v60, 0
    v_mov_b32 v61, 0
    v_lshlrev_b32 v136, 2, v0
    v_add_u32 v137, 1, v136
    v_add_u32 v138, 2, v136
    v_add_u32 v139, 3, v136
    v_mov_b32 v157, 65536
    s_lshl_b32 s72, s40, 2
    s_add_u32 s72, s72, 65536
    v_mov_b32 v158, s72
    v_cmp_eq_u32 s[66:67], 0, v5
    s_cmp_eq_u32 s59, 0
    s_cselect_b32 s75, 5, 5
    v_mov_b32 v155, 65552
    v_mov_b32 v17, s75
    ds_write2_b32 v155, v155, v17 offset0:0 offset1:1
    s_waitcnt vmcnt(5)
    v_add_u32 v63, -1, v62
    v_add_u32 v70, -1, v70
    v_min_u32 v63, 0x7ff, v63
    v_min_u32 v70, 0x7ff, v70
    v_lshl_add_u32 v94, v70, 5, v65
    v_lshl_add_u32 v95, v63, 5, v64
    v_add_u32 v63, 1, v63
    v_sub_u32 v96, v94, v95
    v_lshrrev_b32 v97, 31, v96
    v_sub_u32_dpp v96, v94, v95 row_ror:1 row_mask:0xf bank_mask:0xf
    v_alignbit_b32 v97, v97, v96, 31
    v_sub_u32_dpp v96, v94, v95 row_ror:2 row_mask:0xf bank_mask:0xf
    v_alignbit_b32 v97, v97, v96, 31
    v_sub_u32_dpp v96, v94, v95 row_ror:3 row_mask:0xf bank_mask:0xf
    v_alignbit_b32 v97, v97, v96, 31
    v_sub_u32_dpp v96, v94, v95 row_ror:4 row_mask:0xf bank_mask:0xf
    v_alignbit_b32 v97, v97, v96, 31
    v_sub_u32_dpp v96, v94, v95 row_ror:5 row_mask:0xf bank_mask:0xf
    v_alignbit_b32 v97, v97, v96, 31
    v_sub_u32_dpp v96, v94, v95 row_ror:6 row_mask:0xf bank_mask:0xf
    v_alignbit_b32 v97, v97, v96, 31
    v_sub_u32_dpp v96, v94, v95 row_ror:7 row_mask:0xf bank_mask:0xf
    v_alignbit_b32 v97, v97, v96, 31
    v_sub_u32_dpp v96, v94, v95 row_ror:8 row_mask:0xf bank_mask:0xf
    v_alignbit_b32 v97, v97, v96, 31
    v_sub_u32_dpp v96, v94, v95 row_ror:9 row_mask:0xf bank_mask:0xf
    v_alignbit_b32 v97, v97, v96, 31
    v_sub_u32_dpp v96, v94, v95 row_ror:10 row_mask:0xf bank_mask:0xf
    v_alignbit_b32 v97, v97, v96, 31
    v_sub_u32_dpp v96, v94, v95 row_ror:11 row_mask:0xf bank_mask:0xf
    v_alignbit_b32 v97, v97, v96, 31
    v_sub_u32_dpp v96, v94, v95 row_ror:12 row_mask:0xf bank_mask:0xf
    v_alignbit_b32 v97, v97, v96, 31
    v_sub_u32_dpp v96, v94, v95 row_ror:13 row_mask:0xf bank_mask:0xf
    v_alignbit_b32 v97, v97, v96, 31
    v_sub_u32_dpp v96, v94, v95 row_ror:14 row_mask:0xf bank_mask:0xf
    v_alignbit_b32 v97, v97, v96, 31
    v_sub_u32_dpp v96, v94, v95 row_ror:15 row_mask:0xf bank_mask:0xf
    v_alignbit_b32 v97, v97, v96, 31
    v_bcnt_u32_b32 v97, v97, 0
    v_mov_b32 v96, v97
    s_nop 1
    v_permlane32_swap_b32 v96, v97
    v_add_u32 v97, v96, v97
    v_cmp_eq_u32 s[60:61], s96, v97
    v_cmp_eq_u32 s[62:63], s97, v97
    v_cmp_eq_u32 s[64:65], 0, v97
    s_ff1_i32_b32 s43, s60
    s_ff1_i32_b32 s44, s62
    s_ff1_i32_b32 s69, s64
    s_min_u32 s3, s43, s44
    s_max_u32 s44, s43, s44
    s_mov_b32 s43, s3
    v_readlane_b32 s45, v63, s43
    v_readlane_b32 s46, v63, s44
    v_readlane_b32 s47, v63, s69
    v_readlane_b32 s70, v62, s43
    v_readlane_b32 s71, v62, s44
    s_cmp_ge_u32 s40, 4
    s_cbranch_scc1 L_coll
    s_lshl_b32 s99, s43, 9
    s_lshl_b32 s92, s40, 2
    v_lshl_add_u32 v64, v0, 4, s99
    s_sub_u32 s94, s45, s92
    s_sub_u32 s93, 12, s92
    s_add_u32 s96, s94, 15
    s_lshr_b32 s96, s96, 4
    s_lshl_b32 s92, s92, 12
    s_lshl_b32 s72, s41, 8
    s_add_u32 s92, s92, s72
    s_lshr_b32 s47, s47, 6
    s_waitcnt vmcnt(0)
    ds_write_b128 v69, v[76:79] offset:49152
    ds_write_b128 v69, v[80:83] offset:50176
    ds_write_b128 v69, v[84:87] offset:51200
    ds_write_b128 v69, v[88:91] offset:52224
    v_xor_b32 v97, v76, v72
    v_xor_b32 v96, v84, v72
    v_bitop3_b32 v97, v97, v77, v73 bitop3:0xf6
    v_bitop3_b32 v96, v96, v85, v73 bitop3:0xf6
    v_bitop3_b32 v97, v97, v78, v74 bitop3:0xf6
    v_bitop3_b32 v96, v96, v86, v74 bitop3:0xf6
    v_bitop3_b32 v97, v97, v79, v75 bitop3:0xf6
    v_bitop3_b32 v96, v96, v87, v75 bitop3:0xf6
    v_bitop3_b32 v97, v97, v80, v72 bitop3:0xf6
    v_bitop3_b32 v96, v96, v88, v72 bitop3:0xf6
    v_bitop3_b32 v97, v97, v81, v73 bitop3:0xf6
    v_bitop3_b32 v96, v96, v89, v73 bitop3:0xf6
    v_bitop3_b32 v97, v97, v82, v74 bitop3:0xf6
    v_bitop3_b32 v96, v96, v90, v74 bitop3:0xf6
    v_bitop3_b32 v97, v97, v83, v75 bitop3:0xf6
    v_bitop3_b32 v96, v96, v91, v75 bitop3:0xf6
    v_or_b32 v97, v97, v96
    v_cmp_ne_u32 vcc, 0, v97
    s_or_b32 s69, vcc_lo, vcc_hi
    s_ff1_i32_b32 s69, s69
    v_mov_b32 v96, s69
    ds_write_b32 v158, v96
    s_waitcnt lgkmcnt(0)
    s_barrier
    ds_read_b128 v[68:71], v157
    ds_read_b128 v[12:15], v64 offset:49152
    s_setprio 1
    s_waitcnt lgkmcnt(1)
    v_min3_u32 v68, v68, v69, v70
    v_min3_u32 v68, v68, v71, s47
    s_waitcnt lgkmcnt(0)
    v_readfirstlane_b32 s47, v68
    v_lshl_add_u32 v12, v12, 16, s92
    v_lshl_add_u32 v13, v13, 16, s92
    v_lshl_add_u32 v14, v14, 16, s92
    v_lshl_add_u32 v15, v15, 16, s92
    s_and_b32 s49, s47, 4294967294
    v_readlane_b32 s50, v12, s49
    v_readlane_b32 s51, v13, s49
    v_readlane_b32 s52, v14, s49
    v_readlane_b32 s53, v15, s49
    s_lshr_b32 s98, s49, 1
    s_lshl_b32 s98, s98, 1
    s_cmp_eq_u32 s59, 0
    s_cselect_b32 s98, 0, s98
    s_lshr_b32 s3, s96, 2
    s_cmp_gt_u32 s3, s49
    s_cselect_b32 s3, s98, 1
    s_cmp_lg_u32 s3, 0
    s_cbranch_scc1 L_lst
    buffer_load_dwordx4 v[64:67], v1, s[16:19], s50 offen nt
    buffer_load_dwordx4 v[68:71], v1, s[16:19], s51 offen nt
    buffer_load_dwordx4 v[72:75], v1, s[16:19], s52 offen nt
    buffer_load_dwordx4 v[76:79], v1, s[16:19], s53 offen nt
    buffer_load_dwordx4 v[80:83], v2, s[20:23], s50 offen nt
L_lst:
    s_lshl_b32 s75, s41, 9
    s_lshl_b32 s73, s43, 13
    s_lshl_b32 s74, s44, 13
    s_add_u32 s73, s73, s75
    s_add_u32 s74, s74, s75
    s_cmp_lt_i32 s70, 1
    s_cselect_b32 s70, 1073741824, s73
    s_cmp_lt_i32 s71, 1
    s_cselect_b32 s71, 1073741824, s74
    v_mov_b32 v152, s71
    v_mov_b32 v153, s70
    v_cndmask_b32 v152, v152, v153, s[66:67]
    v_add_u32 v39, v39, v152
    buffer_load_dwordx4 v[18:21], v39, s[24:27], 0 offen
    s_sub_u32 s95, s46, s93
    s_add_u32 s97, s95, 15
    s_lshr_b32 s97, s97, 4
    s_add_u32 s48, s96, s97
    v_cmp_gt_u32 s[60:61], s96, v136
    v_cmp_gt_u32 s[62:63], s96, v137
    v_cmp_gt_u32 s[64:65], s96, v138
    v_cmp_gt_u32 s[66:67], s96, v139
    s_sub_u32 s75, s44, s43
    s_lshl_b32 s97, s75, 7
    s_add_u32 s97, s97, s48
    s_sub_u32 s97, s97, 1
    v_sub_u32 v140, s97, v136
    v_sub_u32 v141, s97, v137
    v_sub_u32 v142, s97, v138
    v_sub_u32 v143, s97, v139
    s_lshl_b32 s75, s75, 11
    s_add_u32 s95, s95, s75
    v_cndmask_b32 v140, v140, v136, s[60:61]
    v_cndmask_b32 v141, v141, v137, s[62:63]
    v_cndmask_b32 v142, v142, v138, s[64:65]
    v_cndmask_b32 v143, v143, v139, s[66:67]
    s_lshl_b32 s93, s93, 12
    s_add_u32 s93, s93, s72
    v_lshl_add_u32 v144, v140, 2, s99
    ds_read_b32 v12, v144 offset:49152
    v_lshl_add_u32 v145, v141, 2, s99
    ds_read_b32 v13, v145 offset:49152
    v_lshl_add_u32 v146, v142, 2, s99
    ds_read_b32 v14, v146 offset:49152
    v_lshl_add_u32 v147, v143, 2, s99
    ds_read_b32 v15, v147 offset:49152
    v_mov_b32 v152, s92
    v_mov_b32 v153, s93
    v_mov_b32 v154, s94
    v_mov_b32 v155, s95
    s_lshl_b32 s72, s49, 2
    s_sub_u32 s72, s48, s72
    v_cndmask_b32 v148, v153, v152, s[60:61]
    v_cndmask_b32 v149, v153, v152, s[62:63]
    v_cndmask_b32 v150, v153, v152, s[64:65]
    v_cndmask_b32 v151, v153, v152, s[66:67]
    v_cndmask_b32 v128, v155, v154, s[60:61]
    v_cndmask_b32 v129, v155, v154, s[62:63]
    v_cndmask_b32 v130, v155, v154, s[64:65]
    v_cndmask_b32 v131, v155, v154, s[66:67]
    v_cndmask_b32 v132, 16, 1, s[60:61]
    v_cndmask_b32 v133, 16, 1, s[62:63]
    v_cndmask_b32 v134, 16, 1, s[64:65]
    v_cndmask_b32 v135, 16, 1, s[66:67]
    v_cmp_gt_u32 s[60:61], s72, v136
    v_cmp_gt_u32 s[62:63], s72, v137
    v_cmp_gt_u32 s[64:65], s72, v138
    v_cmp_gt_u32 s[66:67], s72, v139
    s_add_u32 s48, s72, 3
    s_lshr_b32 s48, s48, 2
    v_mov_b32 v155, 1073741824
    v_mad_i32_i24 v128, v140, -16, v128
    v_mad_i32_i24 v129, v141, -16, v129
    v_mad_i32_i24 v130, v142, -16, v130
    v_mad_i32_i24 v131, v143, -16, v131
    v_cndmask_b32 v132, 0, v132, s[60:61]
    v_cndmask_b32 v133, 0, v133, s[62:63]
    v_cndmask_b32 v134, 0, v134, s[64:65]
    v_cndmask_b32 v135, 0, v135, s[66:67]
    s_add_u32 s68, s49, 1
    v_med3_i32 v128, v128, 0, 4
    v_med3_i32 v129, v129, 0, 4
    v_med3_i32 v130, v130, 0, 4
    v_med3_i32 v131, v131, 0, 4
    s_waitcnt lgkmcnt(0)
    v_lshl_add_u32 v12, v12, 16, v148
    v_lshl_add_u32 v13, v13, 16, v149
    v_lshl_add_u32 v14, v14, 16, v150
    v_lshl_add_u32 v15, v15, 16, v151
    v_cndmask_b32 v12, v155, v12, s[60:61]
    v_cndmask_b32 v13, v155, v13, s[62:63]
    v_cndmask_b32 v14, v155, v14, s[64:65]
    v_cndmask_b32 v15, v155, v15, s[66:67]
    v_mul_u32_u24 v128, v128, v132
    v_mul_u32_u24 v129, v129, v133
    v_mul_u32_u24 v130, v130, v134
    v_mul_u32_u24 v131, v131, v135
    v_readlane_b32 s50, v12, s49
    v_readlane_b32 s51, v13, s49
    v_readlane_b32 s52, v14, s49
    v_readlane_b32 s53, v15, s49
    v_readlane_b32 s54, v12, s68
    v_readlane_b32 s55, v13, s68
    v_readlane_b32 s56, v14, s68
    v_readlane_b32 s57, v15, s68
    v_lshl_or_b32 v128, v129, 8, v128
    v_lshl_or_b32 v130, v131, 8, v130
    v_lshl_or_b32 v16, v130, 16, v128
    s_cmp_lg_u32 s98, 0
    s_cbranch_scc1 L_shwg
    s_cmp_eq_u32 s3, 0
    s_cbranch_scc1 L_main
    buffer_load_dwordx4 v[64:67], v1, s[16:19], s50 offen nt
    buffer_load_dwordx4 v[68:71], v1, s[16:19], s51 offen nt
    buffer_load_dwordx4 v[72:75], v1, s[16:19], s52 offen nt
    buffer_load_dwordx4 v[76:79], v1, s[16:19], s53 offen nt
    buffer_load_dwordx4 v[80:83], v2, s[20:23], s50 offen nt
L_main:
    v_mov_b32 v39, 65552
    s_mul_i32 s70, s40, 2176
    s_add_u32 s70, s70, 0
    v_lshl_add_u32 v160, v0, 4, s70
    s_lshl_b32 s71, s40, 2
    s_add_u32 s71, s71, 10752
    v_bfe_u32 v161, v0, 2, 2
    v_lshl_add_u32 v161, v161, 5, s71
    s_lshl_b32 s72, s40, 5
    s_add_u32 s72, s72, 10752
    v_mov_b32 v62, s72
    s_lshl_b32 s72, s40, 6
    s_add_u32 s72, s72, 0
    v_lshl_add_u32 v162, v8, 8, s72
    v_and_b32 v163, 1, v0
    v_lshl_add_u32 v162, v163, 5, v162
    v_bfe_u32 v163, v0, 2, 2
    v_lshl_add_u32 v162, v163, 2, v162
    v_bfe_u32 v163, v0, 1, 1
    v_mul_u32_u24 v163, 1088, v163
    v_add_u32 v162, v162, v163
    v_add_u32 v163, 2176, v162
    v_add_u32 v164, 4352, v162
    v_add_u32 v165, 6528, v162
    s_lshl_b32 s72, s40, 8
    s_add_u32 s72, s72, 8704
    v_lshl_add_u32 v166, v8, 6, s72
    v_bfe_u32 v63, v0, 1, 2
    v_lshl_add_u32 v166, v63, 4, v166
    v_bfe_u32 v63, v0, 3, 1
    v_lshl_add_u32 v166, v63, 3, v166
    v_and_b32 v63, 1, v0
    v_lshl_add_u32 v166, v63, 2, v166
    s_cmp_ge_u32 s40, 2
    s_cselect_b32 s75, s74, s73
    s_and_b32 s70, s40, 1
    s_lshl_b32 s70, s70, 8
    s_add_u32 s75, s75, s70
    v_lshlrev_b32 v63, 2, v0
    s_cmp_ge_u32 s49, s48
    s_cbranch_scc1 L_epi
    s_waitcnt vmcnt(4)
    buffer_load_dwordx4 v[84:87], v2, s[20:23], s51 offen nt
    s_waitcnt vmcnt(4)
    buffer_load_dwordx4 v[88:91], v2, s[20:23], s52 offen nt
    s_waitcnt vmcnt(4)
    buffer_load_dwordx4 v[92:95], v2, s[20:23], s53 offen nt
    s_waitcnt vmcnt(4)
    buffer_load_dwordx4 v[96:99], v1, s[16:19], s54 offen nt
    s_waitcnt vmcnt(4)
    buffer_load_dwordx4 v[100:103], v1, s[16:19], s55 offen nt
    s_waitcnt vmcnt(4)
    buffer_load_dwordx4 v[104:107], v1, s[16:19], s56 offen nt
    s_waitcnt vmcnt(4)
    buffer_load_dwordx4 v[108:111], v1, s[16:19], s57 offen nt
    s_waitcnt vmcnt(4)
    buffer_load_dwordx4 v[112:115], v2, s[20:23], s54 offen nt
    s_waitcnt vmcnt(4)
    buffer_load_dwordx4 v[116:119], v2, s[20:23], s55 offen nt
L_p0:
    s_add_u32 s68, s49, 2
    v_readlane_b32 s58, v16, s49
    v_readlane_b32 s50, v12, s68
    v_readlane_b32 s51, v13, s68
    v_readlane_b32 s52, v14, s68
    v_readlane_b32 s53, v15, s68
    v_bfe_u32 v35, s58, v5, 4
    v_bfe_u32 v36, s58, v9, 4
    v_bfe_u32 v37, s58, v10, 4
    v_bfe_u32 v38, s58, v11, 4
    s_sub_u32 s69, s48, s49
    v_mov_b32 v33, s69
    ds_write_b32 v39, v33
    s_cmp_le_u32 s69, 5
    s_cselect_b64 vcc, -1, 0
    s_add_u32 s49, s49, 1
    v_cmp_gt_u32 s[60:61], v35, v8
    v_cmp_gt_u32 s[62:63], v36, v8
    v_cmp_gt_u32 s[64:65], v37, v8
    v_cmp_gt_u32 s[66:67], v38, v8
    v_cndmask_b32 v35, v7, 0, s[60:61]
    v_cndmask_b32 v36, v7, 0, s[62:63]
    v_cndmask_b32 v37, v7, 0, s[64:65]
    v_cndmask_b32 v38, v7, 0, s[66:67]
    s_cbranch_vccnz 1
    s_waitcnt vmcnt(4)
    s_waitcnt vmcnt(13)
    buffer_load_dwordx4 v[120:123], v2, s[20:23], s56 offen nt
    v_mfma_f32_16x16x32_bf16 v[40:43], v[64:67], v[18:21], 0
    s_cbranch_vccnz 1
    s_waitcnt vmcnt(4)
    s_waitcnt vmcnt(13)
    buffer_load_dwordx4 v[124:127], v2, s[20:23], s57 offen nt
    v_mfma_f32_16x16x32_bf16 v[44:47], v[68:71], v[18:21], 0
    s_cbranch_vccnz 1
    s_waitcnt vmcnt(4)
    s_waitcnt vmcnt(13)
    buffer_load_dwordx4 v[64:67], v1, s[16:19], s50 offen nt
    v_mfma_f32_16x16x32_bf16 v[48:51], v[72:75], v[18:21], 0
    s_nop 1
    v_fmac_f32_dpp v35, v40, v6 quad_perm:[0,0,0,0] row_mask:0xf bank_mask:0xf
    v_fmac_f32_dpp v35, v41, v6 quad_perm:[1,1,1,1] row_mask:0xf bank_mask:0xf
    v_fmac_f32_dpp v35, v42, v6 quad_perm:[2,2,2,2] row_mask:0xf bank_mask:0xf
    v_fmac_f32_dpp v35, v43, v6 quad_perm:[3,3,3,3] row_mask:0xf bank_mask:0xf
    s_cbranch_vccnz 1
    s_waitcnt vmcnt(4)
    s_waitcnt vmcnt(13)
    buffer_load_dwordx4 v[68:71], v1, s[16:19], s51 offen nt
    v_mfma_f32_16x16x32_bf16 v[40:43], v[76:79], v[18:21], 0
    v_fmac_f32_dpp v36, v44, v6 quad_perm:[0,0,0,0] row_mask:0xf bank_mask:0xf
    v_fmac_f32_dpp v36, v45, v6 quad_perm:[1,1,1,1] row_mask:0xf bank_mask:0xf
    v_fmac_f32_dpp v36, v46, v6 quad_perm:[2,2,2,2] row_mask:0xf bank_mask:0xf
    v_fmac_f32_dpp v36, v47, v6 quad_perm:[3,3,3,3] row_mask:0xf bank_mask:0xf
    v_fmac_f32_dpp v37, v48, v6 quad_perm:[0,0,0,0] row_mask:0xf bank_mask:0xf
    v_fmac_f32_dpp v37, v49, v6 quad_perm:[1,1,1,1] row_mask:0xf bank_mask:0xf
    v_fmac_f32_dpp v37, v50, v6 quad_perm:[2,2,2,2] row_mask:0xf bank_mask:0xf
    v_fmac_f32_dpp v37, v51, v6 quad_perm:[3,3,3,3] row_mask:0xf bank_mask:0xf
    v_fmac_f32_dpp v38, v40, v6 quad_perm:[0,0,0,0] row_mask:0xf bank_mask:0xf
    v_fmac_f32_dpp v38, v41, v6 quad_perm:[1,1,1,1] row_mask:0xf bank_mask:0xf
    v_fmac_f32_dpp v38, v42, v6 quad_perm:[2,2,2,2] row_mask:0xf bank_mask:0xf
    v_fmac_f32_dpp v38, v43, v6 quad_perm:[3,3,3,3] row_mask:0xf bank_mask:0xf
    v_max3_f32 v33, v35, v36, v37
    v_max3_f32 v33, v33, v38, v30
    v_mov_b32 v34, v33
    s_nop 1
    v_permlane16_swap_b32 v34, v33
    v_max_f32 v33, v33, v34
    v_mov_b32 v34, v33
    s_nop 1
    v_permlane32_swap_b32 v34, v33
    v_max_f32 v33, v33, v34
    v_sub_f32 v32, v30, v33
    v_sub_f32 v35, v35, v33
    v_sub_f32 v36, v36, v33
    v_sub_f32 v37, v37, v33
    v_sub_f32 v38, v38, v33
    v_exp_f32 v32, v32
    v_exp_f32 v35, v35
    v_exp_f32 v36, v36
    v_exp_f32 v37, v37
    v_exp_f32 v38, v38
    v_mov_b32 v30, v33
    v_cvt_pk_bf16_f32 v40, v35, v35
    v_cvt_pk_bf16_f32 v41, v36, v36
    v_cvt_pk_bf16_f32 v42, v37, v37
    v_cvt_pk_bf16_f32 v43, v38, v38
    v_mul_f32 v22, v32, v22
    v_mul_f32 v23, v32, v23
    v_mul_f32 v24, v32, v24
    v_mul_f32 v25, v32, v25
    v_mul_f32 v26, v32, v26
    v_mul_f32 v27, v32, v27
    v_mul_f32 v28, v32, v28
    v_mul_f32 v29, v32, v29
    v_and_b32 v54, v3, v40
    v_and_b32 v55, v4, v40
    v_and_b32 v58, v3, v41
    v_and_b32 v59, v4, v41
    v_fma_f32 v31, v31, v32, v35
    v_add_f32 v36, v36, v37
    v_add_f32 v31, v31, v38
    v_add_f32 v31, v31, v36
    s_cbranch_vccnz 1
    s_waitcnt vmcnt(4)
    s_waitcnt vmcnt(13)
    buffer_load_dwordx4 v[72:75], v1, s[16:19], s52 offen nt
    v_mfma_f32_16x16x32_bf16 v[22:25], v[80:83], v[54:57], v[22:25]
    v_mfma_f32_16x16x32_bf16 v[26:29], v[80:83], v[52:55], v[26:29]
    v_and_b32 v54, v3, v42
    v_and_b32 v55, v4, v42
    s_cbranch_vccnz 1
    s_waitcnt vmcnt(4)
    s_waitcnt vmcnt(13)
    buffer_load_dwordx4 v[76:79], v1, s[16:19], s53 offen nt
    v_mfma_f32_16x16x32_bf16 v[22:25], v[84:87], v[58:61], v[22:25]
    v_mfma_f32_16x16x32_bf16 v[26:29], v[84:87], v[56:59], v[26:29]
    v_and_b32 v58, v3, v43
    v_and_b32 v59, v4, v43
    s_cbranch_vccnz 1
    s_waitcnt vmcnt(4)
    s_waitcnt vmcnt(13)
    buffer_load_dwordx4 v[80:83], v2, s[20:23], s50 offen nt
    v_mfma_f32_16x16x32_bf16 v[22:25], v[88:91], v[54:57], v[22:25]
    v_mfma_f32_16x16x32_bf16 v[26:29], v[88:91], v[52:55], v[26:29]
    s_cbranch_vccnz 1
    s_waitcnt vmcnt(4)
    s_waitcnt vmcnt(13)
    buffer_load_dwordx4 v[84:87], v2, s[20:23], s51 offen nt
    v_mfma_f32_16x16x32_bf16 v[22:25], v[92:95], v[58:61], v[22:25]
    v_mfma_f32_16x16x32_bf16 v[26:29], v[92:95], v[56:59], v[26:29]
    s_cmp_ge_u32 s49, s48
    s_cbranch_scc1 L_epi
L_p1:
    s_add_u32 s68, s49, 2
    v_readlane_b32 s58, v16, s49
    v_readlane_b32 s54, v12, s68
    v_readlane_b32 s55, v13, s68
    v_readlane_b32 s56, v14, s68
    v_readlane_b32 s57, v15, s68
    v_bfe_u32 v35, s58, v5, 4
    v_bfe_u32 v36, s58, v9, 4
    v_bfe_u32 v37, s58, v10, 4
    v_bfe_u32 v38, s58, v11, 4
    s_sub_u32 s69, s48, s49
    v_mov_b32 v33, s69
    ds_write_b32 v39, v33
    s_cmp_le_u32 s69, 5
    s_cselect_b64 vcc, -1, 0
    s_add_u32 s49, s49, 1
    v_cmp_gt_u32 s[60:61], v35, v8
    v_cmp_gt_u32 s[62:63], v36, v8
    v_cmp_gt_u32 s[64:65], v37, v8
    v_cmp_gt_u32 s[66:67], v38, v8
    v_cndmask_b32 v35, v7, 0, s[60:61]
    v_cndmask_b32 v36, v7, 0, s[62:63]
    v_cndmask_b32 v37, v7, 0, s[64:65]
    v_cndmask_b32 v38, v7, 0, s[66:67]
    s_cbranch_vccnz 1
    s_waitcnt vmcnt(4)
    s_waitcnt vmcnt(13)
    buffer_load_dwordx4 v[88:91], v2, s[20:23], s52 offen nt
    v_mfma_f32_16x16x32_bf16 v[40:43], v[96:99], v[18:21], 0
    s_cbranch_vccnz 1
    s_waitcnt vmcnt(4)
    s_waitcnt vmcnt(13)
    buffer_load_dwordx4 v[92:95], v2, s[20:23], s53 offen nt
    v_mfma_f32_16x16x32_bf16 v[44:47], v[100:103], v[18:21], 0
    s_cbranch_vccnz 1
    s_waitcnt vmcnt(4)
    s_waitcnt vmcnt(13)
    buffer_load_dwordx4 v[96:99], v1, s[16:19], s54 offen nt
    v_mfma_f32_16x16x32_bf16 v[48:51], v[104:107], v[18:21], 0
    s_nop 1
    v_fmac_f32_dpp v35, v40, v6 quad_perm:[0,0,0,0] row_mask:0xf bank_mask:0xf
    v_fmac_f32_dpp v35, v41, v6 quad_perm:[1,1,1,1] row_mask:0xf bank_mask:0xf
    v_fmac_f32_dpp v35, v42, v6 quad_perm:[2,2,2,2] row_mask:0xf bank_mask:0xf
    v_fmac_f32_dpp v35, v43, v6 quad_perm:[3,3,3,3] row_mask:0xf bank_mask:0xf
    s_cbranch_vccnz 1
    s_waitcnt vmcnt(4)
    s_waitcnt vmcnt(13)
    buffer_load_dwordx4 v[100:103], v1, s[16:19], s55 offen nt
    v_mfma_f32_16x16x32_bf16 v[40:43], v[108:111], v[18:21], 0
    v_fmac_f32_dpp v36, v44, v6 quad_perm:[0,0,0,0] row_mask:0xf bank_mask:0xf
    v_fmac_f32_dpp v36, v45, v6 quad_perm:[1,1,1,1] row_mask:0xf bank_mask:0xf
    v_fmac_f32_dpp v36, v46, v6 quad_perm:[2,2,2,2] row_mask:0xf bank_mask:0xf
    v_fmac_f32_dpp v36, v47, v6 quad_perm:[3,3,3,3] row_mask:0xf bank_mask:0xf
    v_fmac_f32_dpp v37, v48, v6 quad_perm:[0,0,0,0] row_mask:0xf bank_mask:0xf
    v_fmac_f32_dpp v37, v49, v6 quad_perm:[1,1,1,1] row_mask:0xf bank_mask:0xf
    v_fmac_f32_dpp v37, v50, v6 quad_perm:[2,2,2,2] row_mask:0xf bank_mask:0xf
    v_fmac_f32_dpp v37, v51, v6 quad_perm:[3,3,3,3] row_mask:0xf bank_mask:0xf
    v_fmac_f32_dpp v38, v40, v6 quad_perm:[0,0,0,0] row_mask:0xf bank_mask:0xf
    v_fmac_f32_dpp v38, v41, v6 quad_perm:[1,1,1,1] row_mask:0xf bank_mask:0xf
    v_fmac_f32_dpp v38, v42, v6 quad_perm:[2,2,2,2] row_mask:0xf bank_mask:0xf
    v_fmac_f32_dpp v38, v43, v6 quad_perm:[3,3,3,3] row_mask:0xf bank_mask:0xf
    v_max3_f32 v33, v35, v36, v37
    v_max3_f32 v33, v33, v38, v30
    v_mov_b32 v34, v33
    s_nop 1
    v_permlane16_swap_b32 v34, v33
    v_max_f32 v33, v33, v34
    v_mov_b32 v34, v33
    s_nop 1
    v_permlane32_swap_b32 v34, v33
    v_max_f32 v33, v33, v34
    v_sub_f32 v32, v30, v33
    v_sub_f32 v35, v35, v33
    v_sub_f32 v36, v36, v33
    v_sub_f32 v37, v37, v33
    v_sub_f32 v38, v38, v33
    v_exp_f32 v32, v32
    v_exp_f32 v35, v35
    v_exp_f32 v36, v36
    v_exp_f32 v37, v37
    v_exp_f32 v38, v38
    v_mov_b32 v30, v33
    v_cvt_pk_bf16_f32 v40, v35, v35
    v_cvt_pk_bf16_f32 v41, v36, v36
    v_cvt_pk_bf16_f32 v42, v37, v37
    v_cvt_pk_bf16_f32 v43, v38, v38
    v_mul_f32 v22, v32, v22
    v_mul_f32 v23, v32, v23
    v_mul_f32 v24, v32, v24
    v_mul_f32 v25, v32, v25
    v_mul_f32 v26, v32, v26
    v_mul_f32 v27, v32, v27
    v_mul_f32 v28, v32, v28
    v_mul_f32 v29, v32, v29
    v_and_b32 v54, v3, v40
    v_and_b32 v55, v4, v40
    v_and_b32 v58, v3, v41
    v_and_b32 v59, v4, v41
    v_fma_f32 v31, v31, v32, v35
    v_add_f32 v36, v36, v37
    v_add_f32 v31, v31, v38
    v_add_f32 v31, v31, v36
    s_cbranch_vccnz 1
    s_waitcnt vmcnt(4)
    s_waitcnt vmcnt(13)
    buffer_load_dwordx4 v[104:107], v1, s[16:19], s56 offen nt
    v_mfma_f32_16x16x32_bf16 v[22:25], v[112:115], v[54:57], v[22:25]
    v_mfma_f32_16x16x32_bf16 v[26:29], v[112:115], v[52:55], v[26:29]
    v_and_b32 v54, v3, v42
    v_and_b32 v55, v4, v42
    s_cbranch_vccnz 1
    s_waitcnt vmcnt(4)
    s_waitcnt vmcnt(13)
    buffer_load_dwordx4 v[108:111], v1, s[16:19], s57 offen nt
    v_mfma_f32_16x16x32_bf16 v[22:25], v[116:119], v[58:61], v[22:25]
    v_mfma_f32_16x16x32_bf16 v[26:29], v[116:119], v[56:59], v[26:29]
    v_and_b32 v58, v3, v43
    v_and_b32 v59, v4, v43
    s_cbranch_vccnz 1
    s_waitcnt vmcnt(4)
    s_waitcnt vmcnt(13)
    buffer_load_dwordx4 v[112:115], v2, s[20:23], s54 offen nt
    v_mfma_f32_16x16x32_bf16 v[22:25], v[120:123], v[54:57], v[22:25]
    v_mfma_f32_16x16x32_bf16 v[26:29], v[120:123], v[52:55], v[26:29]
    s_cbranch_vccnz 1
    s_waitcnt vmcnt(4)
    s_waitcnt vmcnt(13)
    buffer_load_dwordx4 v[116:119], v2, s[20:23], s55 offen nt
    v_mfma_f32_16x16x32_bf16 v[22:25], v[124:127], v[58:61], v[22:25]
    v_mfma_f32_16x16x32_bf16 v[26:29], v[124:127], v[56:59], v[26:29]
    s_cmp_ge_u32 s49, s48
    s_cbranch_scc0 L_p0
L_epi:
    v_mov_b32 v33, 0
    ds_write_b32 v39, v33
    v_mov_b32 v34, v31
    s_nop 1
    v_permlane16_swap_b32 v34, v31
    v_add_f32 v31, v31, v34
    v_mov_b32 v34, v31
    s_nop 1
    v_permlane32_swap_b32 v34, v31
    v_add_f32 v31, v31, v34
    ds_write2_b32 v161, v30, v31 offset0:0 offset1:32
    ds_write_b128 v160, v[22:25]
    ds_write_b128 v160, v[26:29] offset:1088
    s_waitcnt vmcnt(0) lgkmcnt(0)
    s_barrier
    ds_read_b128 v[64:67], v62
    ds_read_b128 v[68:71], v62 offset:16
    ds_read_b128 v[72:75], v62 offset:128
    ds_read_b128 v[76:79], v62 offset:144
    ds_read2_b32 v[80:81], v162 offset0:0 offset1:4
    ds_read2_b32 v[82:83], v163 offset0:0 offset1:4
    ds_read2_b32 v[84:85], v164 offset0:0 offset1:4
    ds_read2_b32 v[86:87], v165 offset0:0 offset1:4
    ds_read_b32 v89, v166 offset:0
    ds_read_b32 v91, v166 offset:1024
    s_waitcnt lgkmcnt(8)
    v_max3_f32 v33, v64, v65, v66
    v_max3_f32 v33, v33, v67, v68
    v_max_f32 v33, v33, v69
    v_sub_f32 v64, v64, v33
    v_sub_f32 v65, v65, v33
    v_sub_f32 v66, v66, v33
    v_sub_f32 v67, v67, v33
    v_sub_f32 v68, v68, v33
    v_sub_f32 v69, v69, v33
    v_exp_f32 v64, v64
    v_exp_f32 v65, v65
    v_exp_f32 v66, v66
    v_exp_f32 v67, v67
    v_exp_f32 v68, v68
    v_exp_f32 v69, v69
    s_waitcnt lgkmcnt(6)
    v_mul_f32 v33, v64, v72
    v_fmac_f32 v33, v65, v73
    v_fmac_f32 v33, v66, v74
    v_fmac_f32 v33, v67, v75
    v_fmac_f32 v33, v68, v76
    v_fmac_f32 v33, v69, v77
    v_rcp_f32 v33, v33
    s_waitcnt lgkmcnt(0)
    v_lshlrev_b32 v88, 16, v89
    v_and_b32 v89, 0xffff0000, v89
    v_lshlrev_b32 v90, 16, v91
    v_and_b32 v91, 0xffff0000, v91
    v_mul_f32 v34, v64, v80
    v_mul_f32 v32, v64, v81
    v_fmac_f32 v34, v65, v82
    v_fmac_f32 v32, v65, v83
    v_fmac_f32 v34, v66, v84
    v_fmac_f32 v32, v66, v85
    v_fmac_f32 v34, v67, v86
    v_fmac_f32 v32, v67, v87
    v_fmac_f32 v34, v68, v88
    v_fmac_f32 v32, v68, v89
    v_fmac_f32 v34, v69, v90
    v_fmac_f32 v32, v69, v91
    v_mul_f32 v34, v34, v33
    v_mul_f32 v32, v32, v33
    v_cvt_pk_bf16_f32 v34, v34, v32
    buffer_store_dword v34, v63, s[36:39], s75 offen
    s_branch L_fin
L_coll:
    s_waitcnt vmcnt(0) lgkmcnt(0)
    s_barrier
    ds_read_b128 v[68:71], v157
    s_lshr_b32 s47, s47, 6
    s_waitcnt lgkmcnt(0)
    v_min3_u32 v68, v68, v69, v70
    v_min3_u32 v68, v68, v71, s47
    v_lshlrev_b32 v1, 4, v0
    v_readfirstlane_b32 s47, v68
    v_and_b32 v4, 3, v0
    v_lshlrev_b32 v4, 5, v4
    v_lshrrev_b32 v5, 2, v0
    v_lshl_add_u32 v4, v5, 2, v4
    v_add_u32 v4, 10768, v4
    s_lshr_b32 s47, s47, 1
    s_lshl_b32 s98, s47, 1
    s_cmp_eq_u32 s98, 0
    s_cbranch_scc1 L_c2
    s_cmp_eq_u32 s59, 0
    s_cbranch_scc1 L_c2
    s_mul_i32 s71, s98, s42
    s_lshl_b32 s71, s71, 3
    v_lshl_add_u32 v20, v0, 3, s71
    ds_read_b64 v[16:17], v20 offset:49152
    v_and_b32 v21, 15, v0
    v_lshrrev_b32 v22, 4, v0
    v_add_u32 v23, 0, v22
    v_lshlrev_b32 v25, 12, v23
    v_xor_b32 v24, v23, v21
    v_lshl_add_u32 v8, v24, 4, v25
    v_and_b32 v24, 7, v23
    v_lshlrev_b32 v24, 1, v24
    v_xor_b32 v24, v24, v21
    v_lshl_add_u32 v12, v24, 4, v25
    v_add_u32 v23, 4, v22
    v_lshlrev_b32 v25, 12, v23
    v_subrev_u32 v25, 1024, v25
    v_xor_b32 v24, v23, v21
    v_lshl_add_u32 v9, v24, 4, v25
    v_and_b32 v24, 7, v23
    v_lshlrev_b32 v24, 1, v24
    v_xor_b32 v24, v24, v21
    v_lshl_add_u32 v13, v24, 4, v25
    v_add_u32 v23, 8, v22
    v_lshlrev_b32 v25, 12, v23
    v_subrev_u32 v25, 2048, v25
    v_xor_b32 v24, v23, v21
    v_lshl_add_u32 v10, v24, 4, v25
    v_and_b32 v24, 7, v23
    v_lshlrev_b32 v24, 1, v24
    v_xor_b32 v24, v24, v21
    v_lshl_add_u32 v14, v24, 4, v25
    v_add_u32 v23, 12, v22
    v_lshlrev_b32 v25, 12, v23
    v_subrev_u32 v25, 3072, v25
    v_xor_b32 v24, v23, v21
    v_lshl_add_u32 v11, v24, 4, v25
    v_and_b32 v24, 7, v23
    v_lshlrev_b32 v24, 1, v24
    v_xor_b32 v24, v24, v21
    v_lshl_add_u32 v15, v24, 4, v25
    s_lshl_b32 s70, s41, 8
    s_waitcnt lgkmcnt(0)
    v_lshl_add_u32 v16, v16, 16, s70
    v_lshl_add_u32 v17, v17, 16, s70
    s_mov_b32 s72, 0
    s_mov_b32 s99, 0
L_lp:
    v_readlane_b32 s50, v16, s72
    v_readlane_b32 s51, v17, s72
    s_and_b32 s75, s72, 3
    s_lshl_b32 s75, s75, 14
    s_add_u32 s72, s72, 1
    s_add_u32 m0, s75, 0
    s_nop 0
    buffer_load_dwordx4 v8, s[16:19], s50 offen offset:0 nt lds
    buffer_load_dwordx4 v9, s[16:19], s50 offen offset:1024 nt lds
    buffer_load_dwordx4 v10, s[16:19], s50 offen offset:2048 nt lds
    buffer_load_dwordx4 v11, s[16:19], s50 offen offset:3072 nt lds
    s_add_u32 m0, s75, 8192
    s_nop 0
    buffer_load_dwordx4 v12, s[20:23], s50 offen offset:0 nt lds
    buffer_load_dwordx4 v13, s[20:23], s50 offen offset:1024 nt lds
    buffer_load_dwordx4 v14, s[20:23], s50 offen offset:2048 nt lds
    buffer_load_dwordx4 v15, s[20:23], s50 offen offset:3072 nt lds
    s_add_u32 m0, s75, 4096
    s_nop 0
    buffer_load_dwordx4 v8, s[16:19], s51 offen offset:0 nt lds
    buffer_load_dwordx4 v9, s[16:19], s51 offen offset:1024 nt lds
    buffer_load_dwordx4 v10, s[16:19], s51 offen offset:2048 nt lds
    buffer_load_dwordx4 v11, s[16:19], s51 offen offset:3072 nt lds
    s_add_u32 m0, s75, 12288
    s_nop 0
    buffer_load_dwordx4 v12, s[20:23], s51 offen offset:0 nt lds
    buffer_load_dwordx4 v13, s[20:23], s51 offen offset:1024 nt lds
    buffer_load_dwordx4 v14, s[20:23], s51 offen offset:2048 nt lds
    buffer_load_dwordx4 v15, s[20:23], s51 offen offset:3072 nt lds
    s_min_u32 s71, s98, 3
    s_cmp_lt_u32 s72, s71
    s_cbranch_scc1 L_lp
L_ll:
    s_sub_u32 s71, s72, s99
    s_cmp_eq_u32 s71, 3
    s_cbranch_scc1 L_lw3
    s_cmp_eq_u32 s71, 2
    s_cbranch_scc1 L_lw2
    s_waitcnt vmcnt(0)
L_lw2:
    s_waitcnt vmcnt(16)
L_lw3:
    s_waitcnt vmcnt(32)
    s_barrier
    s_add_u32 s99, s99, 1
    s_cmp_ge_u32 s72, s98
    s_cbranch_scc1 L_ln
    v_readlane_b32 s50, v16, s72
    v_readlane_b32 s51, v17, s72
    s_and_b32 s75, s72, 3
    s_lshl_b32 s75, s75, 14
    s_add_u32 s72, s72, 1
    s_add_u32 m0, s75, 0
    s_nop 0
    buffer_load_dwordx4 v8, s[16:19], s50 offen offset:0 nt lds
    buffer_load_dwordx4 v9, s[16:19], s50 offen offset:1024 nt lds
    buffer_load_dwordx4 v10, s[16:19], s50 offen offset:2048 nt lds
    buffer_load_dwordx4 v11, s[16:19], s50 offen offset:3072 nt lds
    s_add_u32 m0, s75, 8192
    s_nop 0
    buffer_load_dwordx4 v12, s[20:23], s50 offen offset:0 nt lds
    buffer_load_dwordx4 v13, s[20:23], s50 offen offset:1024 nt lds
    buffer_load_dwordx4 v14, s[20:23], s50 offen offset:2048 nt lds
    buffer_load_dwordx4 v15, s[20:23], s50 offen offset:3072 nt lds
    s_add_u32 m0, s75, 4096
    s_nop 0
    buffer_load_dwordx4 v8, s[16:19], s51 offen offset:0 nt lds
    buffer_load_dwordx4 v9, s[16:19], s51 offen offset:1024 nt lds
    buffer_load_dwordx4 v10, s[16:19], s51 offen offset:2048 nt lds
    buffer_load_dwordx4 v11, s[16:19], s51 offen offset:3072 nt lds
    s_add_u32 m0, s75, 12288
    s_nop 0
    buffer_load_dwordx4 v12, s[20:23], s51 offen offset:0 nt lds
    buffer_load_dwordx4 v13, s[20:23], s51 offen offset:1024 nt lds
    buffer_load_dwordx4 v14, s[20:23], s51 offen offset:2048 nt lds
    buffer_load_dwordx4 v15, s[20:23], s51 offen offset:3072 nt lds
L_ln:
    s_cmp_lt_u32 s99, s98
    s_cbranch_scc1 L_ll
    s_mul_i32 s70, s41, 2
    s_add_u32 s70, s70, s42
    s_lshl_b32 s71, s70, 14
    v_mul_u32_u24 v23, 16, v22
    v_add_u32 v23, v23, v1
    v_lshlrev_b32 v24, 3, v0
    v_add_u32 v25, 65600, v24
    s_barrier
    s_barrier
    ds_read_b64 v[26:27], v25
    ds_read_b128 v[64:67], v23 offset:16384
    ds_read_b128 v[68:71], v23 offset:17472
    ds_read_b128 v[72:75], v23 offset:18560
    ds_read_b128 v[76:79], v23 offset:19648
    ds_read_b128 v[80:83], v23 offset:20736
    ds_read_b128 v[84:87], v23 offset:21824
    ds_read_b128 v[88:91], v23 offset:22912
    ds_read_b128 v[92:95], v23 offset:24000
    s_waitcnt lgkmcnt(7)
    buffer_store_dwordx4 v[64:67], v1, s[88:91], s71 offen offset:0 sc1
    s_waitcnt lgkmcnt(6)
    buffer_store_dwordx4 v[68:71], v1, s[88:91], s71 offen offset:1024 sc1
    s_waitcnt lgkmcnt(5)
    buffer_store_dwordx4 v[72:75], v1, s[88:91], s71 offen offset:2048 sc1
    s_waitcnt lgkmcnt(4)
    buffer_store_dwordx4 v[76:79], v1, s[88:91], s71 offen offset:3072 sc1
    s_add_u32 s71, s71, 4096
    s_waitcnt lgkmcnt(3)
    buffer_store_dwordx4 v[80:83], v1, s[88:91], s71 offen offset:0 sc1
    s_waitcnt lgkmcnt(2)
    buffer_store_dwordx4 v[84:87], v1, s[88:91], s71 offen offset:1024 sc1
    s_waitcnt lgkmcnt(1)
    buffer_store_dwordx4 v[88:91], v1, s[88:91], s71 offen offset:2048 sc1
    s_waitcnt lgkmcnt(0)
    buffer_store_dwordx4 v[92:95], v1, s[88:91], s71 offen offset:3072 sc1
    s_add_u32 s71, s71, 4096
    ds_read_b128 v[96:99], v23 offset:25088
    ds_read_b128 v[100:103], v23 offset:26176
    ds_read_b128 v[104:107], v23 offset:27264
    ds_read_b128 v[108:111], v23 offset:28352
    ds_read_b128 v[112:115], v23 offset:29440
    ds_read_b128 v[116:119], v23 offset:30528
    ds_read_b128 v[120:123], v23 offset:31616
    ds_read_b128 v[124:127], v23 offset:32704
    s_waitcnt lgkmcnt(7)
    buffer_store_dwordx4 v[96:99], v1, s[88:91], s71 offen offset:0 sc1
    s_waitcnt lgkmcnt(6)
    buffer_store_dwordx4 v[100:103], v1, s[88:91], s71 offen offset:1024 sc1
    s_waitcnt lgkmcnt(5)
    buffer_store_dwordx4 v[104:107], v1, s[88:91], s71 offen offset:2048 sc1
    s_waitcnt lgkmcnt(4)
    buffer_store_dwordx4 v[108:111], v1, s[88:91], s71 offen offset:3072 sc1
    s_add_u32 s71, s71, 4096
    s_waitcnt lgkmcnt(3)
    buffer_store_dwordx4 v[112:115], v1, s[88:91], s71 offen offset:0 sc1
    s_waitcnt lgkmcnt(2)
    buffer_store_dwordx4 v[116:119], v1, s[88:91], s71 offen offset:1024 sc1
    s_waitcnt lgkmcnt(1)
    buffer_store_dwordx4 v[120:123], v1, s[88:91], s71 offen offset:2048 sc1
    s_waitcnt lgkmcnt(0)
    buffer_store_dwordx4 v[124:127], v1, s[88:91], s71 offen offset:3072 sc1
    s_add_u32 s71, s71, 4096
    s_lshl_b32 s72, s70, 9
    s_add_u32 s72, s72, 524288
    buffer_store_dwordx2 v[26:27], v24, s[88:91], s72 offen sc1
    s_lshl_b32 s70, s70, 2
    v_mov_b32 v2, 1
    s_waitcnt vmcnt(0)
    s_mov_b64 exec, 1
    buffer_store_dword v2, off, s[84:87], s70 sc1
    s_mov_b64 exec, -1
L_c2:
    v_mov_b32 v2, 65552
L_kend:
    s_cmp_lg_u32 s98, 0
    s_cbranch_scc1 L_c1
    v_mov_b32 v64, 0
    v_mov_b32 v65, 0
    v_mov_b32 v66, 0
    v_mov_b32 v67, 0
    v_mov_b32 v68, 0
    v_mov_b32 v69, 0
    v_mov_b32 v70, 0
    v_mov_b32 v71, 0
    v_mov_b32 v8, 0xf149f2ca
    v_mov_b32 v9, 0
    v_cmp_gt_u32 vcc, 8, v0
    s_and_saveexec_b64 s[60:61], vcc
    s_branch L_c3
L_c1:
L_c4:
    s_sleep 8
    ds_read_b32 v3, v2
    s_waitcnt lgkmcnt(0)
    v_readfirstlane_b32 s71, v3
    s_cmp_gt_u32 s71, 2
    s_cbranch_scc1 L_c4
    s_mul_i32 s70, s41, 8
L_poll:
    buffer_load_dwordx2 v[64:65], off, s[84:87], s70 sc1
    s_waitcnt vmcnt(0)
    v_and_b32 v64, v64, v65
    s_nop 0
    v_readfirstlane_b32 s71, v64
    s_cmp_lg_u32 s71, 0
    s_cbranch_scc1 L_ready
    s_sleep 32
    s_branch L_poll
L_ready:
    s_mul_i32 s70, s41, 32768
    v_mov_b32 v2, s44
    v_mov_b32 v3, s43
    v_cmp_gt_u32 vcc, 32, v0
    v_and_b32 v6, 31, v0
    v_lshlrev_b32 v6, 4, v6
    v_cndmask_b32 v7, v2, v3, vcc
    v_lshl_add_u32 v7, v7, 9, v6
    buffer_load_dwordx4 v[64:67], v7, s[88:91], s70 offen sc1
    s_add_u32 s70, s70, 16384
    buffer_load_dwordx4 v[68:71], v7, s[88:91], s70 offen sc1
    v_and_b32 v6, 2, v0
    v_cmp_eq_u32 vcc, 0, v6
    v_and_b32 v6, 1, v0
    s_nop 0
    v_cndmask_b32 v2, v2, v3, vcc
    v_lshl_add_u32 v2, v2, 1, v6
    v_lshl_add_u32 v2, v5, 6, v2
    v_lshlrev_b32 v2, 3, v2
    s_mul_i32 s70, s41, 1024
    s_add_u32 s70, s70, 524288
    v_cmp_gt_u32 vcc, 8, v0
    s_and_saveexec_b64 s[60:61], vcc
    buffer_load_dwordx2 v[8:9], v2, s[88:91], s70 offen sc1
    s_waitcnt vmcnt(0)
L_c3:
    ds_write2_b32 v4, v8, v9 offset0:0 offset1:32
    s_mov_b64 exec, s[60:61]
    ds_write_b128 v1, v[64:67] offset:8704
    ds_write_b128 v1, v[68:71] offset:9728
    s_waitcnt lgkmcnt(0)
    s_barrier
    s_branch L_fin
L_shwg:
    v_and_b32 v128, 15, v0
    s_lshl_b32 s70, s40, 3
    v_lshrrev_b32 v130, 1, v128
    v_add_u32 v130, s70, v130
    v_lshlrev_b32 v131, 2, v130
    ds_bpermute_b32 v131, v131, v62
    v_and_b32 v132, 1, v0
    v_lshlrev_b32 v132, 8, v132
    v_lshl_add_u32 v132, v8, 4, v132
    v_lshl_add_u32 v132, v130, 13, v132
    v_mov_b32 v133, 1073741824
    s_lshl_b32 s71, s41, 9
    s_waitcnt lgkmcnt(0)
    v_cmp_gt_i32 vcc, 1, v131
    v_xor_b32 v134, v8, v128
    v_lshlrev_b32 v134, 4, v134
    v_cndmask_b32 v132, v132, v133, vcc
    buffer_load_dwordx4 v[44:47], v132, s[24:27], s71 offen offset:0
    buffer_load_dwordx4 v[48:51], v132, s[24:27], s71 offen offset:64
    buffer_load_dwordx4 v[52:55], v132, s[24:27], s71 offen offset:128
    buffer_load_dwordx4 v[56:59], v132, s[24:27], s71 offen offset:192
    v_lshl_add_u32 v26, v128, 8, v134
    v_xor_b32 v27, 64, v26
    v_xor_b32 v28, 128, v26
    v_xor_b32 v29, 192, v26
    v_bfe_u32 v134, v0, 2, 2
    v_lshl_add_u32 v134, v8, 2, v134
    v_and_b32 v135, 7, v134
    v_lshlrev_b32 v135, 5, v135
    v_lshl_add_u32 v135, v134, 8, v135
    v_and_b32 v134, 3, v0
    v_lshl_add_u32 v30, v134, 3, v135
    v_xor_b32 v31, 32, v30
    v_xor_b32 v32, 64, v30
    v_xor_b32 v33, 96, v30
    v_xor_b32 v34, 128, v30
    v_xor_b32 v35, 160, v30
    v_xor_b32 v36, 192, v30
    v_xor_b32 v37, 224, v30
    v_mov_b32 v96, 0
    v_mov_b32 v97, 0
    v_mov_b32 v98, 0
    v_mov_b32 v99, 0
    v_mov_b32 v100, 0
    v_mov_b32 v101, 0
    v_mov_b32 v102, 0
    v_mov_b32 v103, 0
    v_mov_b32 v104, 0
    v_mov_b32 v105, 0
    v_mov_b32 v106, 0
    v_mov_b32 v107, 0
    v_mov_b32 v108, 0
    v_mov_b32 v109, 0
    v_mov_b32 v110, 0
    v_mov_b32 v111, 0
    v_mov_b32 v112, 0
    v_mov_b32 v113, 0
    v_mov_b32 v114, 0
    v_mov_b32 v115, 0
    v_mov_b32 v116, 0
    v_mov_b32 v117, 0
    v_mov_b32 v118, 0
    v_mov_b32 v119, 0
    v_mov_b32 v120, 0
    v_mov_b32 v121, 0
    v_mov_b32 v122, 0
    v_mov_b32 v123, 0
    v_mov_b32 v124, 0
    v_mov_b32 v125, 0
    v_mov_b32 v126, 0
    v_mov_b32 v127, 0
    v_mov_b32 v40, 0xf149f2ca
    v_mov_b32 v41, 0
    s_mov_b32 s92, 0x3e0293ee
    s_mov_b32 s99, 0
    s_sub_u32 s93, s98, 2
    s_cselect_b32 s93, 0, s93
    s_waitcnt vmcnt(0)
L_sh0:
    s_cmp_eq_u32 s99, s93
    s_barrier
    ds_read_b128 v[128:131], v26 offset:0
    ds_read_b128 v[132:135], v26 offset:4096
    ds_read_b128 v[136:139], v27 offset:0
    ds_read_b128 v[140:143], v27 offset:4096
    ds_read_b128 v[144:147], v28 offset:0
    ds_read_b128 v[148:151], v28 offset:4096
    ds_read_b128 v[152:155], v29 offset:0
    ds_read_b128 v[156:159], v29 offset:4096
    s_cbranch_scc1 L_shx0
L_shy0:
    s_add_u32 s99, s99, 1
    s_waitcnt lgkmcnt(6)
    v_mfma_f32_16x16x32_bf16 v[160:163], v[128:131], v[44:47], 0
    v_mfma_f32_16x16x32_bf16 v[164:167], v[132:135], v[44:47], 0
    ds_read_b64_tr_b16 v[128:129], v30 offset:8192
    ds_read_b64_tr_b16 v[130:131], v30 offset:12288
    ds_read_b64_tr_b16 v[132:133], v31 offset:8192
    ds_read_b64_tr_b16 v[134:135], v31 offset:12288
    s_waitcnt lgkmcnt(8)
    v_mfma_f32_16x16x32_bf16 v[160:163], v[136:139], v[48:51], v[160:163]
    v_mfma_f32_16x16x32_bf16 v[164:167], v[140:143], v[48:51], v[164:167]
    ds_read_b64_tr_b16 v[136:137], v32 offset:8192
    ds_read_b64_tr_b16 v[138:139], v32 offset:12288
    ds_read_b64_tr_b16 v[140:141], v33 offset:8192
    ds_read_b64_tr_b16 v[142:143], v33 offset:12288
    s_waitcnt lgkmcnt(10)
    v_mfma_f32_16x16x32_bf16 v[160:163], v[144:147], v[52:55], v[160:163]
    v_mfma_f32_16x16x32_bf16 v[164:167], v[148:151], v[52:55], v[164:167]
    ds_read_b64_tr_b16 v[144:145], v34 offset:8192
    ds_read_b64_tr_b16 v[146:147], v34 offset:12288
    ds_read_b64_tr_b16 v[148:149], v35 offset:8192
    ds_read_b64_tr_b16 v[150:151], v35 offset:12288
    s_waitcnt lgkmcnt(12)
    v_mfma_f32_16x16x32_bf16 v[160:163], v[152:155], v[56:59], v[160:163]
    v_mfma_f32_16x16x32_bf16 v[164:167], v[156:159], v[56:59], v[164:167]
    ds_read_b64_tr_b16 v[152:153], v36 offset:8192
    ds_read_b64_tr_b16 v[154:155], v36 offset:12288
    ds_read_b64_tr_b16 v[156:157], v37 offset:8192
    ds_read_b64_tr_b16 v[158:159], v37 offset:12288
    s_nop 2
    v_max3_f32 v43, v160, v161, v162
    v_max3_f32 v43, v43, v163, v164
    v_max3_f32 v39, v165, v166, v167
    v_max_f32 v43, v43, v39
    v_mov_b32 v39, v43
    s_nop 1
    v_permlane16_swap_b32 v39, v43
    v_max_f32 v43, v43, v39
    v_mov_b32 v39, v43
    s_nop 1
    v_permlane32_swap_b32 v39, v43
    v_max_f32 v43, v43, v39
    v_mul_f32 v43, s92, v43
    v_max_f32 v43, v43, v40
    v_sub_f32 v42, v40, v43
    v_fma_f32 v160, v160, s92, -v43
    v_fma_f32 v161, v161, s92, -v43
    v_fma_f32 v162, v162, s92, -v43
    v_fma_f32 v163, v163, s92, -v43
    v_fma_f32 v164, v164, s92, -v43
    v_fma_f32 v165, v165, s92, -v43
    v_fma_f32 v166, v166, s92, -v43
    v_fma_f32 v167, v167, s92, -v43
    v_exp_f32 v42, v42
    v_exp_f32 v160, v160
    v_exp_f32 v161, v161
    v_exp_f32 v162, v162
    v_exp_f32 v163, v163
    v_exp_f32 v164, v164
    v_exp_f32 v165, v165
    v_exp_f32 v166, v166
    v_exp_f32 v167, v167
    v_mov_b32 v40, v43
    v_cvt_pk_bf16_f32 v60, v160, v161
    v_cvt_pk_bf16_f32 v61, v162, v163
    v_cvt_pk_bf16_f32 v62, v164, v165
    v_cvt_pk_bf16_f32 v63, v166, v167
    v_mul_f32 v96, v42, v96
    v_mul_f32 v97, v42, v97
    v_mul_f32 v98, v42, v98
    v_mul_f32 v99, v42, v99
    v_mul_f32 v100, v42, v100
    v_mul_f32 v101, v42, v101
    v_mul_f32 v102, v42, v102
    v_mul_f32 v103, v42, v103
    v_fma_f32 v41, v41, v42, v160
    s_waitcnt lgkmcnt(0)
    v_mfma_f32_16x16x32_bf16 v[96:99], v[128:131], v[60:63], v[96:99]
    v_mul_f32 v104, v42, v104
    v_mul_f32 v105, v42, v105
    v_mul_f32 v106, v42, v106
    v_mul_f32 v107, v42, v107
    v_add_f32 v41, v41, v161
    v_mfma_f32_16x16x32_bf16 v[100:103], v[132:135], v[60:63], v[100:103]
    v_mul_f32 v108, v42, v108
    v_mul_f32 v109, v42, v109
    v_mul_f32 v110, v42, v110
    v_mul_f32 v111, v42, v111
    v_add_f32 v41, v41, v162
    v_mfma_f32_16x16x32_bf16 v[104:107], v[136:139], v[60:63], v[104:107]
    v_mul_f32 v112, v42, v112
    v_mul_f32 v113, v42, v113
    v_mul_f32 v114, v42, v114
    v_mul_f32 v115, v42, v115
    v_add_f32 v41, v41, v163
    v_mfma_f32_16x16x32_bf16 v[108:111], v[140:143], v[60:63], v[108:111]
    v_mul_f32 v116, v42, v116
    v_mul_f32 v117, v42, v117
    v_mul_f32 v118, v42, v118
    v_mul_f32 v119, v42, v119
    v_add_f32 v41, v41, v164
    v_mfma_f32_16x16x32_bf16 v[112:115], v[144:147], v[60:63], v[112:115]
    v_mul_f32 v120, v42, v120
    v_mul_f32 v121, v42, v121
    v_mul_f32 v122, v42, v122
    v_mul_f32 v123, v42, v123
    v_add_f32 v41, v41, v165
    v_mfma_f32_16x16x32_bf16 v[116:119], v[148:151], v[60:63], v[116:119]
    v_mul_f32 v124, v42, v124
    v_mul_f32 v125, v42, v125
    v_mul_f32 v126, v42, v126
    v_mul_f32 v127, v42, v127
    v_add_f32 v41, v41, v166
    v_mfma_f32_16x16x32_bf16 v[120:123], v[152:155], v[60:63], v[120:123]
    v_add_f32 v41, v41, v167
    v_mfma_f32_16x16x32_bf16 v[124:127], v[156:159], v[60:63], v[124:127]
    s_cmp_ge_u32 s99, s98
    s_cbranch_scc1 L_shout
L_sh1:
    s_cmp_eq_u32 s99, s93
    s_barrier
    ds_read_b128 v[128:131], v26 offset:16384
    ds_read_b128 v[132:135], v26 offset:20480
    ds_read_b128 v[136:139], v27 offset:16384
    ds_read_b128 v[140:143], v27 offset:20480
    ds_read_b128 v[144:147], v28 offset:16384
    ds_read_b128 v[148:151], v28 offset:20480
    ds_read_b128 v[152:155], v29 offset:16384
    ds_read_b128 v[156:159], v29 offset:20480
    s_cbranch_scc1 L_shx1
L_shy1:
    s_add_u32 s99, s99, 1
    s_waitcnt lgkmcnt(6)
    v_mfma_f32_16x16x32_bf16 v[160:163], v[128:131], v[44:47], 0
    v_mfma_f32_16x16x32_bf16 v[164:167], v[132:135], v[44:47], 0
    ds_read_b64_tr_b16 v[128:129], v30 offset:24576
    ds_read_b64_tr_b16 v[130:131], v30 offset:28672
    ds_read_b64_tr_b16 v[132:133], v31 offset:24576
    ds_read_b64_tr_b16 v[134:135], v31 offset:28672
    s_waitcnt lgkmcnt(8)
    v_mfma_f32_16x16x32_bf16 v[160:163], v[136:139], v[48:51], v[160:163]
    v_mfma_f32_16x16x32_bf16 v[164:167], v[140:143], v[48:51], v[164:167]
    ds_read_b64_tr_b16 v[136:137], v32 offset:24576
    ds_read_b64_tr_b16 v[138:139], v32 offset:28672
    ds_read_b64_tr_b16 v[140:141], v33 offset:24576
    ds_read_b64_tr_b16 v[142:143], v33 offset:28672
    s_waitcnt lgkmcnt(10)
    v_mfma_f32_16x16x32_bf16 v[160:163], v[144:147], v[52:55], v[160:163]
    v_mfma_f32_16x16x32_bf16 v[164:167], v[148:151], v[52:55], v[164:167]
    ds_read_b64_tr_b16 v[144:145], v34 offset:24576
    ds_read_b64_tr_b16 v[146:147], v34 offset:28672
    ds_read_b64_tr_b16 v[148:149], v35 offset:24576
    ds_read_b64_tr_b16 v[150:151], v35 offset:28672
    s_waitcnt lgkmcnt(12)
    v_mfma_f32_16x16x32_bf16 v[160:163], v[152:155], v[56:59], v[160:163]
    v_mfma_f32_16x16x32_bf16 v[164:167], v[156:159], v[56:59], v[164:167]
    ds_read_b64_tr_b16 v[152:153], v36 offset:24576
    ds_read_b64_tr_b16 v[154:155], v36 offset:28672
    ds_read_b64_tr_b16 v[156:157], v37 offset:24576
    ds_read_b64_tr_b16 v[158:159], v37 offset:28672
    s_nop 2
    v_max3_f32 v43, v160, v161, v162
    v_max3_f32 v43, v43, v163, v164
    v_max3_f32 v39, v165, v166, v167
    v_max_f32 v43, v43, v39
    v_mov_b32 v39, v43
    s_nop 1
    v_permlane16_swap_b32 v39, v43
    v_max_f32 v43, v43, v39
    v_mov_b32 v39, v43
    s_nop 1
    v_permlane32_swap_b32 v39, v43
    v_max_f32 v43, v43, v39
    v_mul_f32 v43, s92, v43
    v_max_f32 v43, v43, v40
    v_sub_f32 v42, v40, v43
    v_fma_f32 v160, v160, s92, -v43
    v_fma_f32 v161, v161, s92, -v43
    v_fma_f32 v162, v162, s92, -v43
    v_fma_f32 v163, v163, s92, -v43
    v_fma_f32 v164, v164, s92, -v43
    v_fma_f32 v165, v165, s92, -v43
    v_fma_f32 v166, v166, s92, -v43
    v_fma_f32 v167, v167, s92, -v43
    v_exp_f32 v42, v42
    v_exp_f32 v160, v160
    v_exp_f32 v161, v161
    v_exp_f32 v162, v162
    v_exp_f32 v163, v163
    v_exp_f32 v164, v164
    v_exp_f32 v165, v165
    v_exp_f32 v166, v166
    v_exp_f32 v167, v167
    v_mov_b32 v40, v43
    v_cvt_pk_bf16_f32 v60, v160, v161
    v_cvt_pk_bf16_f32 v61, v162, v163
    v_cvt_pk_bf16_f32 v62, v164, v165
    v_cvt_pk_bf16_f32 v63, v166, v167
    v_mul_f32 v96, v42, v96
    v_mul_f32 v97, v42, v97
    v_mul_f32 v98, v42, v98
    v_mul_f32 v99, v42, v99
    v_mul_f32 v100, v42, v100
    v_mul_f32 v101, v42, v101
    v_mul_f32 v102, v42, v102
    v_mul_f32 v103, v42, v103
    v_fma_f32 v41, v41, v42, v160
    s_waitcnt lgkmcnt(0)
    v_mfma_f32_16x16x32_bf16 v[96:99], v[128:131], v[60:63], v[96:99]
    v_mul_f32 v104, v42, v104
    v_mul_f32 v105, v42, v105
    v_mul_f32 v106, v42, v106
    v_mul_f32 v107, v42, v107
    v_add_f32 v41, v41, v161
    v_mfma_f32_16x16x32_bf16 v[100:103], v[132:135], v[60:63], v[100:103]
    v_mul_f32 v108, v42, v108
    v_mul_f32 v109, v42, v109
    v_mul_f32 v110, v42, v110
    v_mul_f32 v111, v42, v111
    v_add_f32 v41, v41, v162
    v_mfma_f32_16x16x32_bf16 v[104:107], v[136:139], v[60:63], v[104:107]
    v_mul_f32 v112, v42, v112
    v_mul_f32 v113, v42, v113
    v_mul_f32 v114, v42, v114
    v_mul_f32 v115, v42, v115
    v_add_f32 v41, v41, v163
    v_mfma_f32_16x16x32_bf16 v[108:111], v[140:143], v[60:63], v[108:111]
    v_mul_f32 v116, v42, v116
    v_mul_f32 v117, v42, v117
    v_mul_f32 v118, v42, v118
    v_mul_f32 v119, v42, v119
    v_add_f32 v41, v41, v164
    v_mfma_f32_16x16x32_bf16 v[112:115], v[144:147], v[60:63], v[112:115]
    v_mul_f32 v120, v42, v120
    v_mul_f32 v121, v42, v121
    v_mul_f32 v122, v42, v122
    v_mul_f32 v123, v42, v123
    v_add_f32 v41, v41, v165
    v_mfma_f32_16x16x32_bf16 v[116:119], v[148:151], v[60:63], v[116:119]
    v_mul_f32 v124, v42, v124
    v_mul_f32 v125, v42, v125
    v_mul_f32 v126, v42, v126
    v_mul_f32 v127, v42, v127
    v_add_f32 v41, v41, v166
    v_mfma_f32_16x16x32_bf16 v[120:123], v[152:155], v[60:63], v[120:123]
    v_add_f32 v41, v41, v167
    v_mfma_f32_16x16x32_bf16 v[124:127], v[156:159], v[60:63], v[124:127]
    s_cmp_ge_u32 s99, s98
    s_cbranch_scc1 L_shout
L_sh2:
    s_cmp_eq_u32 s99, s93
    s_barrier
    ds_read_b128 v[128:131], v26 offset:32768
    ds_read_b128 v[132:135], v26 offset:36864
    ds_read_b128 v[136:139], v27 offset:32768
    ds_read_b128 v[140:143], v27 offset:36864
    ds_read_b128 v[144:147], v28 offset:32768
    ds_read_b128 v[148:151], v28 offset:36864
    ds_read_b128 v[152:155], v29 offset:32768
    ds_read_b128 v[156:159], v29 offset:36864
    s_cbranch_scc1 L_shx2
L_shy2:
    s_add_u32 s99, s99, 1
    s_waitcnt lgkmcnt(6)
    v_mfma_f32_16x16x32_bf16 v[160:163], v[128:131], v[44:47], 0
    v_mfma_f32_16x16x32_bf16 v[164:167], v[132:135], v[44:47], 0
    ds_read_b64_tr_b16 v[128:129], v30 offset:40960
    ds_read_b64_tr_b16 v[130:131], v30 offset:45056
    ds_read_b64_tr_b16 v[132:133], v31 offset:40960
    ds_read_b64_tr_b16 v[134:135], v31 offset:45056
    s_waitcnt lgkmcnt(8)
    v_mfma_f32_16x16x32_bf16 v[160:163], v[136:139], v[48:51], v[160:163]
    v_mfma_f32_16x16x32_bf16 v[164:167], v[140:143], v[48:51], v[164:167]
    ds_read_b64_tr_b16 v[136:137], v32 offset:40960
    ds_read_b64_tr_b16 v[138:139], v32 offset:45056
    ds_read_b64_tr_b16 v[140:141], v33 offset:40960
    ds_read_b64_tr_b16 v[142:143], v33 offset:45056
    s_waitcnt lgkmcnt(10)
    v_mfma_f32_16x16x32_bf16 v[160:163], v[144:147], v[52:55], v[160:163]
    v_mfma_f32_16x16x32_bf16 v[164:167], v[148:151], v[52:55], v[164:167]
    ds_read_b64_tr_b16 v[144:145], v34 offset:40960
    ds_read_b64_tr_b16 v[146:147], v34 offset:45056
    ds_read_b64_tr_b16 v[148:149], v35 offset:40960
    ds_read_b64_tr_b16 v[150:151], v35 offset:45056
    s_waitcnt lgkmcnt(12)
    v_mfma_f32_16x16x32_bf16 v[160:163], v[152:155], v[56:59], v[160:163]
    v_mfma_f32_16x16x32_bf16 v[164:167], v[156:159], v[56:59], v[164:167]
    ds_read_b64_tr_b16 v[152:153], v36 offset:40960
    ds_read_b64_tr_b16 v[154:155], v36 offset:45056
    ds_read_b64_tr_b16 v[156:157], v37 offset:40960
    ds_read_b64_tr_b16 v[158:159], v37 offset:45056
    s_nop 2
    v_max3_f32 v43, v160, v161, v162
    v_max3_f32 v43, v43, v163, v164
    v_max3_f32 v39, v165, v166, v167
    v_max_f32 v43, v43, v39
    v_mov_b32 v39, v43
    s_nop 1
    v_permlane16_swap_b32 v39, v43
    v_max_f32 v43, v43, v39
    v_mov_b32 v39, v43
    s_nop 1
    v_permlane32_swap_b32 v39, v43
    v_max_f32 v43, v43, v39
    v_mul_f32 v43, s92, v43
    v_max_f32 v43, v43, v40
    v_sub_f32 v42, v40, v43
    v_fma_f32 v160, v160, s92, -v43
    v_fma_f32 v161, v161, s92, -v43
    v_fma_f32 v162, v162, s92, -v43
    v_fma_f32 v163, v163, s92, -v43
    v_fma_f32 v164, v164, s92, -v43
    v_fma_f32 v165, v165, s92, -v43
    v_fma_f32 v166, v166, s92, -v43
    v_fma_f32 v167, v167, s92, -v43
    v_exp_f32 v42, v42
    v_exp_f32 v160, v160
    v_exp_f32 v161, v161
    v_exp_f32 v162, v162
    v_exp_f32 v163, v163
    v_exp_f32 v164, v164
    v_exp_f32 v165, v165
    v_exp_f32 v166, v166
    v_exp_f32 v167, v167
    v_mov_b32 v40, v43
    v_cvt_pk_bf16_f32 v60, v160, v161
    v_cvt_pk_bf16_f32 v61, v162, v163
    v_cvt_pk_bf16_f32 v62, v164, v165
    v_cvt_pk_bf16_f32 v63, v166, v167
    v_mul_f32 v96, v42, v96
    v_mul_f32 v97, v42, v97
    v_mul_f32 v98, v42, v98
    v_mul_f32 v99, v42, v99
    v_mul_f32 v100, v42, v100
    v_mul_f32 v101, v42, v101
    v_mul_f32 v102, v42, v102
    v_mul_f32 v103, v42, v103
    v_fma_f32 v41, v41, v42, v160
    s_waitcnt lgkmcnt(0)
    v_mfma_f32_16x16x32_bf16 v[96:99], v[128:131], v[60:63], v[96:99]
    v_mul_f32 v104, v42, v104
    v_mul_f32 v105, v42, v105
    v_mul_f32 v106, v42, v106
    v_mul_f32 v107, v42, v107
    v_add_f32 v41, v41, v161
    v_mfma_f32_16x16x32_bf16 v[100:103], v[132:135], v[60:63], v[100:103]
    v_mul_f32 v108, v42, v108
    v_mul_f32 v109, v42, v109
    v_mul_f32 v110, v42, v110
    v_mul_f32 v111, v42, v111
    v_add_f32 v41, v41, v162
    v_mfma_f32_16x16x32_bf16 v[104:107], v[136:139], v[60:63], v[104:107]
    v_mul_f32 v112, v42, v112
    v_mul_f32 v113, v42, v113
    v_mul_f32 v114, v42, v114
    v_mul_f32 v115, v42, v115
    v_add_f32 v41, v41, v163
    v_mfma_f32_16x16x32_bf16 v[108:111], v[140:143], v[60:63], v[108:111]
    v_mul_f32 v116, v42, v116
    v_mul_f32 v117, v42, v117
    v_mul_f32 v118, v42, v118
    v_mul_f32 v119, v42, v119
    v_add_f32 v41, v41, v164
    v_mfma_f32_16x16x32_bf16 v[112:115], v[144:147], v[60:63], v[112:115]
    v_mul_f32 v120, v42, v120
    v_mul_f32 v121, v42, v121
    v_mul_f32 v122, v42, v122
    v_mul_f32 v123, v42, v123
    v_add_f32 v41, v41, v165
    v_mfma_f32_16x16x32_bf16 v[116:119], v[148:151], v[60:63], v[116:119]
    v_mul_f32 v124, v42, v124
    v_mul_f32 v125, v42, v125
    v_mul_f32 v126, v42, v126
    v_mul_f32 v127, v42, v127
    v_add_f32 v41, v41, v166
    v_mfma_f32_16x16x32_bf16 v[120:123], v[152:155], v[60:63], v[120:123]
    v_add_f32 v41, v41, v167
    v_mfma_f32_16x16x32_bf16 v[124:127], v[156:159], v[60:63], v[124:127]
    s_cmp_ge_u32 s99, s98
    s_cbranch_scc1 L_shout
L_sh3:
    s_cmp_eq_u32 s99, s93
    s_barrier
    ds_read_b128 v[128:131], v26 offset:49152
    ds_read_b128 v[132:135], v26 offset:53248
    ds_read_b128 v[136:139], v27 offset:49152
    ds_read_b128 v[140:143], v27 offset:53248
    ds_read_b128 v[144:147], v28 offset:49152
    ds_read_b128 v[148:151], v28 offset:53248
    ds_read_b128 v[152:155], v29 offset:49152
    ds_read_b128 v[156:159], v29 offset:53248
    s_cbranch_scc1 L_shx3
L_shy3:
    s_add_u32 s99, s99, 1
    s_waitcnt lgkmcnt(6)
    v_mfma_f32_16x16x32_bf16 v[160:163], v[128:131], v[44:47], 0
    v_mfma_f32_16x16x32_bf16 v[164:167], v[132:135], v[44:47], 0
    ds_read_b64_tr_b16 v[128:129], v30 offset:57344
    ds_read_b64_tr_b16 v[130:131], v30 offset:61440
    ds_read_b64_tr_b16 v[132:133], v31 offset:57344
    ds_read_b64_tr_b16 v[134:135], v31 offset:61440
    s_waitcnt lgkmcnt(8)
    v_mfma_f32_16x16x32_bf16 v[160:163], v[136:139], v[48:51], v[160:163]
    v_mfma_f32_16x16x32_bf16 v[164:167], v[140:143], v[48:51], v[164:167]
    ds_read_b64_tr_b16 v[136:137], v32 offset:57344
    ds_read_b64_tr_b16 v[138:139], v32 offset:61440
    ds_read_b64_tr_b16 v[140:141], v33 offset:57344
    ds_read_b64_tr_b16 v[142:143], v33 offset:61440
    s_waitcnt lgkmcnt(10)
    v_mfma_f32_16x16x32_bf16 v[160:163], v[144:147], v[52:55], v[160:163]
    v_mfma_f32_16x16x32_bf16 v[164:167], v[148:151], v[52:55], v[164:167]
    ds_read_b64_tr_b16 v[144:145], v34 offset:57344
    ds_read_b64_tr_b16 v[146:147], v34 offset:61440
    ds_read_b64_tr_b16 v[148:149], v35 offset:57344
    ds_read_b64_tr_b16 v[150:151], v35 offset:61440
    s_waitcnt lgkmcnt(12)
    v_mfma_f32_16x16x32_bf16 v[160:163], v[152:155], v[56:59], v[160:163]
    v_mfma_f32_16x16x32_bf16 v[164:167], v[156:159], v[56:59], v[164:167]
    ds_read_b64_tr_b16 v[152:153], v36 offset:57344
    ds_read_b64_tr_b16 v[154:155], v36 offset:61440
    ds_read_b64_tr_b16 v[156:157], v37 offset:57344
    ds_read_b64_tr_b16 v[158:159], v37 offset:61440
    s_nop 2
    v_max3_f32 v43, v160, v161, v162
    v_max3_f32 v43, v43, v163, v164
    v_max3_f32 v39, v165, v166, v167
    v_max_f32 v43, v43, v39
    v_mov_b32 v39, v43
    s_nop 1
    v_permlane16_swap_b32 v39, v43
    v_max_f32 v43, v43, v39
    v_mov_b32 v39, v43
    s_nop 1
    v_permlane32_swap_b32 v39, v43
    v_max_f32 v43, v43, v39
    v_mul_f32 v43, s92, v43
    v_max_f32 v43, v43, v40
    v_sub_f32 v42, v40, v43
    v_fma_f32 v160, v160, s92, -v43
    v_fma_f32 v161, v161, s92, -v43
    v_fma_f32 v162, v162, s92, -v43
    v_fma_f32 v163, v163, s92, -v43
    v_fma_f32 v164, v164, s92, -v43
    v_fma_f32 v165, v165, s92, -v43
    v_fma_f32 v166, v166, s92, -v43
    v_fma_f32 v167, v167, s92, -v43
    v_exp_f32 v42, v42
    v_exp_f32 v160, v160
    v_exp_f32 v161, v161
    v_exp_f32 v162, v162
    v_exp_f32 v163, v163
    v_exp_f32 v164, v164
    v_exp_f32 v165, v165
    v_exp_f32 v166, v166
    v_exp_f32 v167, v167
    v_mov_b32 v40, v43
    v_cvt_pk_bf16_f32 v60, v160, v161
    v_cvt_pk_bf16_f32 v61, v162, v163
    v_cvt_pk_bf16_f32 v62, v164, v165
    v_cvt_pk_bf16_f32 v63, v166, v167
    v_mul_f32 v96, v42, v96
    v_mul_f32 v97, v42, v97
    v_mul_f32 v98, v42, v98
    v_mul_f32 v99, v42, v99
    v_mul_f32 v100, v42, v100
    v_mul_f32 v101, v42, v101
    v_mul_f32 v102, v42, v102
    v_mul_f32 v103, v42, v103
    v_fma_f32 v41, v41, v42, v160
    s_waitcnt lgkmcnt(0)
    v_mfma_f32_16x16x32_bf16 v[96:99], v[128:131], v[60:63], v[96:99]
    v_mul_f32 v104, v42, v104
    v_mul_f32 v105, v42, v105
    v_mul_f32 v106, v42, v106
    v_mul_f32 v107, v42, v107
    v_add_f32 v41, v41, v161
    v_mfma_f32_16x16x32_bf16 v[100:103], v[132:135], v[60:63], v[100:103]
    v_mul_f32 v108, v42, v108
    v_mul_f32 v109, v42, v109
    v_mul_f32 v110, v42, v110
    v_mul_f32 v111, v42, v111
    v_add_f32 v41, v41, v162
    v_mfma_f32_16x16x32_bf16 v[104:107], v[136:139], v[60:63], v[104:107]
    v_mul_f32 v112, v42, v112
    v_mul_f32 v113, v42, v113
    v_mul_f32 v114, v42, v114
    v_mul_f32 v115, v42, v115
    v_add_f32 v41, v41, v163
    v_mfma_f32_16x16x32_bf16 v[108:111], v[140:143], v[60:63], v[108:111]
    v_mul_f32 v116, v42, v116
    v_mul_f32 v117, v42, v117
    v_mul_f32 v118, v42, v118
    v_mul_f32 v119, v42, v119
    v_add_f32 v41, v41, v164
    v_mfma_f32_16x16x32_bf16 v[112:115], v[144:147], v[60:63], v[112:115]
    v_mul_f32 v120, v42, v120
    v_mul_f32 v121, v42, v121
    v_mul_f32 v122, v42, v122
    v_mul_f32 v123, v42, v123
    v_add_f32 v41, v41, v165
    v_mfma_f32_16x16x32_bf16 v[116:119], v[148:151], v[60:63], v[116:119]
    v_mul_f32 v124, v42, v124
    v_mul_f32 v125, v42, v125
    v_mul_f32 v126, v42, v126
    v_mul_f32 v127, v42, v127
    v_add_f32 v41, v41, v166
    v_mfma_f32_16x16x32_bf16 v[120:123], v[152:155], v[60:63], v[120:123]
    v_add_f32 v41, v41, v167
    v_mfma_f32_16x16x32_bf16 v[124:127], v[156:159], v[60:63], v[124:127]
    s_cmp_ge_u32 s99, s98
    s_cbranch_scc0 L_sh0
L_shout:
    s_barrier
    v_mov_b32 v39, v41
    s_mul_i32 s72, s40, 4352
    s_add_u32 s72, s72, 16384
    v_and_b32 v162, 15, v0
    v_lshl_add_u32 v161, v8, 4, s72
    v_mul_u32_u24 v162, 272, v162
    v_add_u32 v161, v161, v162
    v_permlane16_swap_b32 v39, v41
    v_add_f32 v41, v41, v39
    v_mov_b32 v39, v41
    v_and_b32 v160, 15, v0
    s_lshl_b32 s72, s40, 7
    s_add_u32 s72, s72, 65600
    v_permlane32_swap_b32 v39, v41
    v_add_f32 v41, v41, v39
    v_lshl_add_u32 v160, v160, 3, s72
    v_cvt_pk_bf16_f32 v128, v96, v97
    v_cvt_pk_bf16_f32 v129, v98, v99
    v_cvt_pk_bf16_f32 v130, v100, v101
    v_cvt_pk_bf16_f32 v131, v102, v103
    ds_write_b128 v161, v[128:131] offset:0
    v_cvt_pk_bf16_f32 v132, v104, v105
    v_cvt_pk_bf16_f32 v133, v106, v107
    v_cvt_pk_bf16_f32 v134, v108, v109
    v_cvt_pk_bf16_f32 v135, v110, v111
    ds_write_b128 v161, v[132:135] offset:64
    v_cvt_pk_bf16_f32 v136, v112, v113
    v_cvt_pk_bf16_f32 v137, v114, v115
    v_cvt_pk_bf16_f32 v138, v116, v117
    v_cvt_pk_bf16_f32 v139, v118, v119
    ds_write_b128 v161, v[136:139] offset:128
    v_cvt_pk_bf16_f32 v140, v120, v121
    v_cvt_pk_bf16_f32 v141, v122, v123
    v_cvt_pk_bf16_f32 v142, v124, v125
    v_cvt_pk_bf16_f32 v143, v126, v127
    ds_write_b128 v161, v[140:143] offset:192
    ds_write_b64 v160, v[40:41]
    v_mov_b32 v22, 0
    v_mov_b32 v23, 0
    v_mov_b32 v24, 0
    v_mov_b32 v25, 0
    v_mov_b32 v26, 0
    v_mov_b32 v27, 0
    v_mov_b32 v28, 0
    v_mov_b32 v29, 0
    v_mov_b32 v30, 0xf149f2ca
    v_mov_b32 v31, 0
    v_mov_b32 v52, 0
    v_mov_b32 v53, 0
    v_mov_b32 v56, 0
    v_mov_b32 v57, 0
    v_mov_b32 v60, 0
    v_mov_b32 v61, 0
    s_waitcnt lgkmcnt(0)
    s_barrier
    s_branch L_main
L_shx0:
    buffer_load_dwordx4 v[64:67], v1, s[16:19], s50 offen nt
    buffer_load_dwordx4 v[68:71], v1, s[16:19], s51 offen nt
    buffer_load_dwordx4 v[72:75], v1, s[16:19], s52 offen nt
    buffer_load_dwordx4 v[76:79], v1, s[16:19], s53 offen nt
    buffer_load_dwordx4 v[80:83], v2, s[20:23], s50 offen nt
    s_branch L_shy0
L_shx1:
    buffer_load_dwordx4 v[64:67], v1, s[16:19], s50 offen nt
    buffer_load_dwordx4 v[68:71], v1, s[16:19], s51 offen nt
    buffer_load_dwordx4 v[72:75], v1, s[16:19], s52 offen nt
    buffer_load_dwordx4 v[76:79], v1, s[16:19], s53 offen nt
    buffer_load_dwordx4 v[80:83], v2, s[20:23], s50 offen nt
    s_branch L_shy1
L_shx2:
    buffer_load_dwordx4 v[64:67], v1, s[16:19], s50 offen nt
    buffer_load_dwordx4 v[68:71], v1, s[16:19], s51 offen nt
    buffer_load_dwordx4 v[72:75], v1, s[16:19], s52 offen nt
    buffer_load_dwordx4 v[76:79], v1, s[16:19], s53 offen nt
    buffer_load_dwordx4 v[80:83], v2, s[20:23], s50 offen nt
    s_branch L_shy2
L_shx3:
    buffer_load_dwordx4 v[64:67], v1, s[16:19], s50 offen nt
    buffer_load_dwordx4 v[68:71], v1, s[16:19], s51 offen nt
    buffer_load_dwordx4 v[72:75], v1, s[16:19], s52 offen nt
    buffer_load_dwordx4 v[76:79], v1, s[16:19], s53 offen nt
    buffer_load_dwordx4 v[80:83], v2, s[20:23], s50 offen nt
    s_branch L_shy3
L_fin:
L_end:
    s_endpgm
.section .rodata,"a"
.p2align 6
.amdhsa_kernel standalone__paged_block_table_kv_radixattention__sampling_kernel
  .amdhsa_next_free_vgpr 168
  .amdhsa_next_free_sgpr 102
  .amdhsa_accum_offset 168
  .amdhsa_group_segment_fixed_size 0
  .amdhsa_kernarg_size 64
  .amdhsa_user_sgpr_count 2
  .amdhsa_user_sgpr_kernarg_segment_ptr 1
  .amdhsa_system_sgpr_workgroup_id_x 1
.end_amdhsa_kernel
```
